```python
import torch

def _softmax(x, axis=-1):
    return torch.softmax(x, dim=axis)
def _gelu(x):
    return torch.nn.functional.gelu(x, approximate="tanh")
def _silu(x):
    return torch.nn.functional.silu(x)
def _sigmoid(x):
    return torch.sigmoid(x)
def _layernorm(x, axis=-1, eps=1e-5):
    m = x.mean(dim=axis, keepdim=True)
    v = x.var(dim=axis, keepdim=True, unbiased=False)
    return (x - m) / torch.sqrt(v + eps)
def _scatter_add(tgt, idx, src, axis=0):
    return tgt.clone().index_add_(axis, idx, src)
def _segment_sum(src, seg, n):
    out = torch.zeros((n,) + src.shape[1:], dtype=src.dtype)
    return out.index_add_(0, seg, src)
def _pad(x, pw):
    flat = tuple(v for pair in reversed(pw) for v in pair)
    return torch.nn.functional.pad(x, flat)

kernel_name = 'standalone__low_rank_proj_linformer__sampling'

def setup_inputs():

    _w = (lambda a: (lambda t: t.to(torch.bfloat16) if t.is_floating_point() else t)(torch.as_tensor(a)))
    B, H, Sq, Skv, Dh, R = 8, 32, 4, 2048, 128, 16
    return {
        "q": _w((lambda *s: torch.randn(*s, dtype=torch.bfloat16) * 0.8)(B, H, Sq, Dh)),
        "k": _w((lambda *s: torch.randn(*s, dtype=torch.bfloat16) * 0.8)(B, H, Skv, Dh)),
        "v": _w((lambda *s: torch.randn(*s, dtype=torch.bfloat16) * 0.05)(B, H, Skv, Dh)),
        "e_proj": _w((lambda *s: torch.randn(*s, dtype=torch.bfloat16) * 0.8)(R, Skv) * (Skv ** -0.5)),
        "f_proj": _w((lambda *s: torch.randn(*s, dtype=torch.bfloat16) * 0.05)(R, Skv) * (Skv ** -0.5)),
    }

def reference(q, k, v, e_proj, f_proj):
    B, H, Sq, Dh = q.shape
    kp = torch.einsum("rn,bhnd->bhrd", e_proj, k)
    vp = torch.einsum("rn,bhnd->bhrd", f_proj, v)
    scores = torch.einsum("bhqd,bhrd->bhqr", q, kp) * (Dh ** -0.5)
    p = _softmax(scores, axis=-1)
    o = torch.einsum("bhqr,bhrd->bhqd", p, vp)
    return o
```

```asm
; @launch grid=(256,1,1) block=(128,1,1) lds=90000
.amdgcn_target "amdgcn-amd-amdhsa--gfx950"
.text
.globl standalone__low_rank_proj_linformer__sampling_kernel
.p2align 12
.p2align 8
.type standalone__low_rank_proj_linformer__sampling_kernel,@function
standalone__low_rank_proj_linformer__sampling_kernel:
    s_cmp_ge_u32 s2, 256
    s_cbranch_scc1 L_end
    s_load_dwordx16 s[4:19], s[0:1], 0
    v_readfirstlane_b32 s3, v0
    v_and_b32 v0, 63, v0
    v_mov_b32 v5, 8704
    v_mov_b32 v8, 0
    v_mov_b32 v9, 1
    ds_write_b64 v5, v[8:9]
    v_and_b32 v10, 15, v0
    v_lshrrev_b32 v11, 4, v0
    v_lshrrev_b32 v13, 1, v11
    v_lshlrev_b32 v13, 16, v13
    v_and_b32 v12, 1, v11
    v_lshl_add_u32 v13, v12, 11, v13
    v_lshl_add_u32 v1, v10, 4, v13
    v_lshrrev_b32 v13, 7, v13
    v_lshl_add_u32 v2, v10, 12, v13
    v_lshlrev_b32 v3, 4, v0
    s_lshr_b32 s42, s2, 3
    s_mul_i32 s42, s42, 7
    s_lshr_b32 s41, s42, 4
    s_lshl_b32 s41, s41, 17
    s_and_b32 s42, s42, 15
    s_lshl_b32 s42, s42, 12
    s_or_b32 s42, s42, s41
    s_and_b32 s52, s42, 454656
    s_lshl_b32 s47, s2, 19
    s_mov_b32 s22, 0x80000
    s_mov_b32 s23, 0x20000
    s_lshr_b32 s43, s52, 7
    s_mov_b32 s26, 0x10000
    s_mov_b32 s27, 0x20000
    s_lshl_b32 s48, s2, 10
    s_mov_b32 s38, 0x400
    s_mov_b32 s39, 0x20000
    s_cmp_ge_u32 s3, 64
    s_waitcnt lgkmcnt(0)
    s_barrier
    s_cbranch_scc1 L_helper
    s_add_u32 s20, s6, s47
    s_addc_u32 s21, s7, 0
    s_mov_b32 s24, s10
    s_mov_b32 s25, s11
    buffer_load_dwordx4 a[32:35], v2, s[24:27], s43 offen
    s_or_b32 s53, s52, 65536
    s_add_u32 s53, s53, 4096
    s_and_b32 s53, s53, 454656
    s_lshr_b32 s43, s53, 7
    buffer_load_dwordx4 a[36:39], v2, s[24:27], s43 offen
    s_or_b32 s54, s53, 65536
    s_add_u32 s54, s54, 4096
    s_and_b32 s54, s54, 454656
    s_lshr_b32 s43, s54, 7
    buffer_load_dwordx4 v[20:23], v2, s[24:27], s43 offen
    s_or_b32 s55, s54, 65536
    s_add_u32 s55, s55, 4096
    s_and_b32 s55, s55, 454656
    s_lshr_b32 s43, s55, 7
    buffer_load_dwordx4 v[24:27], v2, s[24:27], s43 offen
    buffer_load_dwordx4 v[92:95], v1, s[20:23], s52 offen nt
    buffer_load_dwordx4 v[96:99], v1, s[20:23], s52 offen offset:256 nt
    buffer_load_dwordx4 v[100:103], v1, s[20:23], s52 offen offset:512 nt
    buffer_load_dwordx4 v[104:107], v1, s[20:23], s52 offen offset:768 nt
    buffer_load_dwordx4 v[108:111], v1, s[20:23], s52 offen offset:1024 nt
    buffer_load_dwordx4 v[112:115], v1, s[20:23], s52 offen offset:1280 nt
    buffer_load_dwordx4 v[116:119], v1, s[20:23], s52 offen offset:1536 nt
    buffer_load_dwordx4 v[120:123], v1, s[20:23], s52 offen offset:1792 nt
    s_or_b32 s52, s55, 65536
    s_add_u32 s52, s52, 4096
    s_and_b32 s52, s52, 454656
    s_lshr_b32 s43, s52, 7
    buffer_load_dwordx4 v[12:15], v2, s[24:27], s43 offen
    buffer_load_dwordx4 v[124:127], v1, s[20:23], s53 offen nt
    buffer_load_dwordx4 v[128:131], v1, s[20:23], s53 offen offset:256 nt
    buffer_load_dwordx4 v[132:135], v1, s[20:23], s53 offen offset:512 nt
    buffer_load_dwordx4 v[136:139], v1, s[20:23], s53 offen offset:768 nt
    buffer_load_dwordx4 v[140:143], v1, s[20:23], s53 offen offset:1024 nt
    buffer_load_dwordx4 v[144:147], v1, s[20:23], s53 offen offset:1280 nt
    buffer_load_dwordx4 v[148:151], v1, s[20:23], s53 offen offset:1536 nt
    buffer_load_dwordx4 v[152:155], v1, s[20:23], s53 offen offset:1792 nt
    s_or_b32 s53, s52, 65536
    s_add_u32 s53, s53, 4096
    s_and_b32 s53, s53, 454656
    s_lshr_b32 s43, s53, 7
    buffer_load_dwordx4 v[16:19], v2, s[24:27], s43 offen
    buffer_load_dwordx4 v[156:159], v1, s[20:23], s54 offen nt
    buffer_load_dwordx4 v[160:163], v1, s[20:23], s54 offen offset:256 nt
    buffer_load_dwordx4 v[164:167], v1, s[20:23], s54 offen offset:512 nt
    buffer_load_dwordx4 v[168:171], v1, s[20:23], s54 offen offset:768 nt
    buffer_load_dwordx4 v[172:175], v1, s[20:23], s54 offen offset:1024 nt
    buffer_load_dwordx4 v[176:179], v1, s[20:23], s54 offen offset:1280 nt
    s_add_u32 s50, s8, s47
    s_addc_u32 s51, s9, 0
    s_add_u32 s36, s14, s48
    s_addc_u32 s37, s15, 0
    s_mov_b32 s44, 0x05040100
    s_mov_b32 s45, 0x07060302
    s_mov_b32 s46, 0
    s_movk_i32 s41, 8704
    v_lshlrev_b32 v4, 3, v0
    v_mov_b32 v6, 1
    v_lshl_add_u32 v11, v0, 2, v5
    v_add_u32 v11, 4, v11
    v_writelane_b32 v11, s41, 0
    s_mov_b64 vcc, -1
    v_mov_b32 v28, 0
    v_mov_b32 v29, 0
    v_mov_b32 v30, 0
    v_mov_b32 v31, 0
    s_nop 1
    v_mfma_f32_16x16x32_bf16 a[44:47], v[28:31], v[28:31], 0
    v_mfma_f32_32x32x16_bf16 v[60:75], v[28:31], v[28:31], 0
    v_mfma_f32_32x32x16_bf16 v[76:91], v[28:31], v[28:31], 0
    v_mfma_f32_32x32x16_bf16 a[0:15], v[28:31], v[28:31], 0
    v_mfma_f32_32x32x16_bf16 a[16:31], v[28:31], v[28:31], 0
    v_mfma_f32_32x32x16_bf16 v[220:235], v[28:31], v[28:31], 0
    v_mfma_f32_32x32x16_bf16 v[236:251], v[28:31], v[28:31], 0
    s_nop 7
    s_nop 4
L_k:
    s_cbranch_vccz L_rxK_0_0
    s_waitcnt vmcnt(19)
L_rxK_0_0:
    s_waitcnt vmcnt(22)
    buffer_load_dwordx4 v[180:183], v1, s[20:23], s54 offen offset:1536 nt
    buffer_load_dwordx4 v[184:187], v1, s[20:23], s54 offen offset:1792 nt
    v_accvgpr_write_b32 a40, v20
    v_accvgpr_write_b32 a41, v21
    v_accvgpr_write_b32 a42, v22
    v_accvgpr_write_b32 a43, v23
    s_or_b32 s54, s53, 65536
    s_add_u32 s54, s54, 4096
    s_and_b32 s54, s54, 454656
    s_lshr_b32 s43, s54, 7
    buffer_load_dwordx4 v[20:23], v2, s[24:27], s43 offen
    v_perm_b32 v28, v96, v92, s44
    v_perm_b32 v32, v96, v92, s45
    v_perm_b32 v36, v97, v93, s44
    v_perm_b32 v40, v97, v93, s45
    v_mfma_f32_16x16x32_bf16 a[0:3], v[60:63], a[44:47], a[0:3]
    v_perm_b32 v44, v98, v94, s44
    v_perm_b32 v48, v98, v94, s45
    v_perm_b32 v52, v99, v95, s44
    v_perm_b32 v56, v99, v95, s45
    v_mfma_f32_16x16x32_bf16 a[4:7], v[64:67], a[44:47], a[4:7]
    s_cbranch_vccz L_rxK_0_1
    s_waitcnt vmcnt(20)
L_rxK_0_1:
    s_waitcnt vmcnt(23)
    buffer_load_dwordx4 v[188:191], v1, s[20:23], s55 offen nt
    buffer_load_dwordx4 v[192:195], v1, s[20:23], s55 offen offset:256 nt
    v_perm_b32 v29, v104, v100, s44
    v_perm_b32 v33, v104, v100, s45
    v_perm_b32 v37, v105, v101, s44
    v_perm_b32 v41, v105, v101, s45
    v_mfma_f32_16x16x32_bf16 a[8:11], v[68:71], a[44:47], a[8:11]
    v_perm_b32 v45, v106, v102, s44
    v_perm_b32 v49, v106, v102, s45
    v_perm_b32 v53, v107, v103, s44
    v_perm_b32 v57, v107, v103, s45
    v_mfma_f32_16x16x32_bf16 a[12:15], v[72:75], a[44:47], a[12:15]
    s_cbranch_vccz L_rxK_0_2
    s_waitcnt vmcnt(19)
L_rxK_0_2:
    s_waitcnt vmcnt(23)
    buffer_load_dwordx4 v[196:199], v1, s[20:23], s55 offen offset:512 nt
    buffer_load_dwordx4 v[200:203], v1, s[20:23], s55 offen offset:768 nt
    v_perm_b32 v30, v112, v108, s44
    v_perm_b32 v34, v112, v108, s45
    v_perm_b32 v38, v113, v109, s44
    v_perm_b32 v42, v113, v109, s45
    v_mfma_f32_16x16x32_bf16 a[16:19], v[76:79], a[44:47], a[16:19]
    v_perm_b32 v46, v114, v110, s44
    v_perm_b32 v50, v114, v110, s45
    v_perm_b32 v54, v115, v111, s44
    v_perm_b32 v58, v115, v111, s45
    v_mfma_f32_16x16x32_bf16 a[20:23], v[80:83], a[44:47], a[20:23]
    s_cbranch_vccz L_rxK_0_3
    s_waitcnt vmcnt(19)
L_rxK_0_3:
    s_waitcnt vmcnt(23)
    buffer_load_dwordx4 v[204:207], v1, s[20:23], s55 offen offset:1024 nt
    buffer_load_dwordx4 v[208:211], v1, s[20:23], s55 offen offset:1280 nt
    v_perm_b32 v31, v120, v116, s44
    v_perm_b32 v35, v120, v116, s45
    v_perm_b32 v39, v121, v117, s44
    v_perm_b32 v43, v121, v117, s45
    v_mfma_f32_16x16x32_bf16 a[24:27], v[84:87], a[44:47], a[24:27]
    v_perm_b32 v47, v122, v118, s44
    v_perm_b32 v51, v122, v118, s45
    v_perm_b32 v55, v123, v119, s44
    v_perm_b32 v59, v123, v119, s45
    v_mfma_f32_16x16x32_bf16 a[28:31], v[88:91], a[44:47], a[28:31]
    s_cbranch_vccz L_rxK_1_0
    s_waitcnt vmcnt(19)
L_rxK_1_0:
    s_waitcnt vmcnt(22)
    buffer_load_dwordx4 v[212:215], v1, s[20:23], s55 offen offset:1536 nt
    buffer_load_dwordx4 v[216:219], v1, s[20:23], s55 offen offset:1792 nt
    v_accvgpr_write_b32 a44, v24
    v_accvgpr_write_b32 a45, v25
    v_accvgpr_write_b32 a46, v26
    v_accvgpr_write_b32 a47, v27
    s_or_b32 s55, s54, 65536
    s_add_u32 s55, s55, 4096
    s_and_b32 s55, s55, 454656
    s_lshr_b32 s43, s55, 7
    buffer_load_dwordx4 v[24:27], v2, s[24:27], s43 offen
    v_perm_b32 v60, v128, v124, s44
    v_perm_b32 v64, v128, v124, s45
    v_perm_b32 v68, v129, v125, s44
    v_perm_b32 v72, v129, v125, s45
    v_mfma_f32_16x16x32_bf16 a[0:3], v[28:31], a[32:35], a[0:3]
    v_perm_b32 v76, v130, v126, s44
    v_perm_b32 v80, v130, v126, s45
    v_perm_b32 v84, v131, v127, s44
    v_perm_b32 v88, v131, v127, s45
    v_mfma_f32_16x16x32_bf16 a[4:7], v[32:35], a[32:35], a[4:7]
    s_cbranch_vccz L_rxK_1_1
    s_waitcnt vmcnt(20)
L_rxK_1_1:
    s_waitcnt vmcnt(23)
    s_cmp_eq_u32 s46, 15
    s_cselect_b64 s[20:21], s[50:51], s[20:21]
    buffer_load_dwordx4 v[92:95], v1, s[20:23], s52 offen nt
    buffer_load_dwordx4 v[96:99], v1, s[20:23], s52 offen offset:256 nt
    v_perm_b32 v61, v136, v132, s44
    v_perm_b32 v65, v136, v132, s45
    v_perm_b32 v69, v137, v133, s44
    v_perm_b32 v73, v137, v133, s45
    v_mfma_f32_16x16x32_bf16 a[8:11], v[36:39], a[32:35], a[8:11]
    v_perm_b32 v77, v138, v134, s44
    v_perm_b32 v81, v138, v134, s45
    v_perm_b32 v85, v139, v135, s44
    v_perm_b32 v89, v139, v135, s45
    v_mfma_f32_16x16x32_bf16 a[12:15], v[40:43], a[32:35], a[12:15]
    s_cbranch_vccz L_rxK_1_2
    s_waitcnt vmcnt(19)
L_rxK_1_2:
    s_waitcnt vmcnt(23)
    buffer_load_dwordx4 v[100:103], v1, s[20:23], s52 offen offset:512 nt
    buffer_load_dwordx4 v[104:107], v1, s[20:23], s52 offen offset:768 nt
    v_perm_b32 v62, v144, v140, s44
    v_perm_b32 v66, v144, v140, s45
    v_perm_b32 v70, v145, v141, s44
    v_perm_b32 v74, v145, v141, s45
    v_mfma_f32_16x16x32_bf16 a[16:19], v[44:47], a[32:35], a[16:19]
    v_perm_b32 v78, v146, v142, s44
    v_perm_b32 v82, v146, v142, s45
    v_perm_b32 v86, v147, v143, s44
    v_perm_b32 v90, v147, v143, s45
    v_mfma_f32_16x16x32_bf16 a[20:23], v[48:51], a[32:35], a[20:23]
    ds_read_b32 v10, v5 offset:4
    s_cbranch_vccz L_rxK_1_3
    s_waitcnt vmcnt(19)
L_rxK_1_3:
    s_waitcnt vmcnt(23)
    buffer_load_dwordx4 v[108:111], v1, s[20:23], s52 offen offset:1024 nt
    buffer_load_dwordx4 v[112:115], v1, s[20:23], s52 offen offset:1280 nt
    v_perm_b32 v63, v152, v148, s44
    v_perm_b32 v67, v152, v148, s45
    v_perm_b32 v71, v153, v149, s44
    v_perm_b32 v75, v153, v149, s45
    v_mfma_f32_16x16x32_bf16 a[24:27], v[52:55], a[32:35], a[24:27]
    v_perm_b32 v79, v154, v150, s44
    v_perm_b32 v83, v154, v150, s45
    v_perm_b32 v87, v155, v151, s44
    v_perm_b32 v91, v155, v151, s45
    v_mfma_f32_16x16x32_bf16 a[28:31], v[56:59], a[32:35], a[28:31]
    s_waitcnt lgkmcnt(0)
    v_cmp_ne_u32 vcc, 0, v10
    s_cbranch_vccz L_rxK_2_0
    s_waitcnt vmcnt(19)
L_rxK_2_0:
    s_waitcnt vmcnt(22)
    buffer_load_dwordx4 v[116:119], v1, s[20:23], s52 offen offset:1536 nt
    buffer_load_dwordx4 v[120:123], v1, s[20:23], s52 offen offset:1792 nt
    v_accvgpr_write_b32 a32, v12
    v_accvgpr_write_b32 a33, v13
    v_accvgpr_write_b32 a34, v14
    v_accvgpr_write_b32 a35, v15
    s_cmp_eq_u32 s46, 14
    s_cselect_b64 s[24:25], s[12:13], s[24:25]
    s_or_b32 s52, s55, 65536
    s_add_u32 s52, s52, 4096
    s_and_b32 s52, s52, 454656
    s_lshr_b32 s43, s52, 7
    buffer_load_dwordx4 v[12:15], v2, s[24:27], s43 offen
    v_perm_b32 v28, v160, v156, s44
    v_perm_b32 v32, v160, v156, s45
    v_perm_b32 v36, v161, v157, s44
    v_perm_b32 v40, v161, v157, s45
    v_mfma_f32_16x16x32_bf16 a[0:3], v[60:63], a[36:39], a[0:3]
    v_perm_b32 v44, v162, v158, s44
    v_perm_b32 v48, v162, v158, s45
    v_perm_b32 v52, v163, v159, s44
    v_perm_b32 v56, v163, v159, s45
    v_mfma_f32_16x16x32_bf16 a[4:7], v[64:67], a[36:39], a[4:7]
    s_cbranch_vccz L_rxK_2_1
    s_waitcnt vmcnt(20)
L_rxK_2_1:
    s_waitcnt vmcnt(23)
    buffer_load_dwordx4 v[124:127], v1, s[20:23], s53 offen nt
    buffer_load_dwordx4 v[128:131], v1, s[20:23], s53 offen offset:256 nt
    v_perm_b32 v29, v168, v164, s44
    v_perm_b32 v33, v168, v164, s45
    v_perm_b32 v37, v169, v165, s44
    v_perm_b32 v41, v169, v165, s45
    v_mfma_f32_16x16x32_bf16 a[8:11], v[68:71], a[36:39], a[8:11]
    v_perm_b32 v45, v170, v166, s44
    v_perm_b32 v49, v170, v166, s45
    v_perm_b32 v53, v171, v167, s44
    v_perm_b32 v57, v171, v167, s45
    v_mfma_f32_16x16x32_bf16 a[12:15], v[72:75], a[36:39], a[12:15]
    s_cbranch_vccz L_rxK_2_2
    s_waitcnt vmcnt(19)
L_rxK_2_2:
    s_waitcnt vmcnt(23)
    buffer_load_dwordx4 v[132:135], v1, s[20:23], s53 offen offset:512 nt
    buffer_load_dwordx4 v[136:139], v1, s[20:23], s53 offen offset:768 nt
    v_perm_b32 v30, v176, v172, s44
    v_perm_b32 v34, v176, v172, s45
    v_perm_b32 v38, v177, v173, s44
    v_perm_b32 v42, v177, v173, s45
    v_mfma_f32_16x16x32_bf16 a[16:19], v[76:79], a[36:39], a[16:19]
    v_perm_b32 v46, v178, v174, s44
    v_perm_b32 v50, v178, v174, s45
    v_perm_b32 v54, v179, v175, s44
    v_perm_b32 v58, v179, v175, s45
    v_mfma_f32_16x16x32_bf16 a[20:23], v[80:83], a[36:39], a[20:23]
    s_cbranch_vccz L_rxK_2_3
    s_waitcnt vmcnt(19)
L_rxK_2_3:
    s_waitcnt vmcnt(23)
    buffer_load_dwordx4 v[140:143], v1, s[20:23], s53 offen offset:1024 nt
    buffer_load_dwordx4 v[144:147], v1, s[20:23], s53 offen offset:1280 nt
    v_perm_b32 v31, v184, v180, s44
    v_perm_b32 v35, v184, v180, s45
    v_perm_b32 v39, v185, v181, s44
    v_perm_b32 v43, v185, v181, s45
    v_mfma_f32_16x16x32_bf16 a[24:27], v[84:87], a[36:39], a[24:27]
    v_perm_b32 v47, v186, v182, s44
    v_perm_b32 v51, v186, v182, s45
    v_perm_b32 v55, v187, v183, s44
    v_perm_b32 v59, v187, v183, s45
    v_mfma_f32_16x16x32_bf16 a[28:31], v[88:91], a[36:39], a[28:31]
    s_cbranch_vccz L_rxK_3_0
    s_waitcnt vmcnt(19)
L_rxK_3_0:
    s_waitcnt vmcnt(22)
    buffer_load_dwordx4 v[148:151], v1, s[20:23], s53 offen offset:1536 nt
    buffer_load_dwordx4 v[152:155], v1, s[20:23], s53 offen offset:1792 nt
    v_accvgpr_write_b32 a36, v16
    v_accvgpr_write_b32 a37, v17
    v_accvgpr_write_b32 a38, v18
    v_accvgpr_write_b32 a39, v19
    s_or_b32 s53, s52, 65536
    s_add_u32 s53, s53, 4096
    s_and_b32 s53, s53, 454656
    s_lshr_b32 s43, s53, 7
    buffer_load_dwordx4 v[16:19], v2, s[24:27], s43 offen
    v_perm_b32 v60, v192, v188, s44
    v_perm_b32 v64, v192, v188, s45
    v_perm_b32 v68, v193, v189, s44
    v_perm_b32 v72, v193, v189, s45
    v_mfma_f32_16x16x32_bf16 a[0:3], v[28:31], a[40:43], a[0:3]
    v_perm_b32 v76, v194, v190, s44
    v_perm_b32 v80, v194, v190, s45
    v_perm_b32 v84, v195, v191, s44
    v_perm_b32 v88, v195, v191, s45
    v_mfma_f32_16x16x32_bf16 a[4:7], v[32:35], a[40:43], a[4:7]
    s_cbranch_vccz L_rxK_3_1
    s_waitcnt vmcnt(20)
L_rxK_3_1:
    s_waitcnt vmcnt(23)
    buffer_load_dwordx4 v[156:159], v1, s[20:23], s54 offen nt
    buffer_load_dwordx4 v[160:163], v1, s[20:23], s54 offen offset:256 nt
    v_perm_b32 v61, v200, v196, s44
    v_perm_b32 v65, v200, v196, s45
    v_perm_b32 v69, v201, v197, s44
    v_perm_b32 v73, v201, v197, s45
    v_mfma_f32_16x16x32_bf16 a[8:11], v[36:39], a[40:43], a[8:11]
    v_perm_b32 v77, v202, v198, s44
    v_perm_b32 v81, v202, v198, s45
    v_perm_b32 v85, v203, v199, s44
    v_perm_b32 v89, v203, v199, s45
    v_mfma_f32_16x16x32_bf16 a[12:15], v[40:43], a[40:43], a[12:15]
    s_cbranch_vccz L_rxK_3_2
    s_waitcnt vmcnt(19)
L_rxK_3_2:
    s_waitcnt vmcnt(23)
    buffer_load_dwordx4 v[164:167], v1, s[20:23], s54 offen offset:512 nt
    buffer_load_dwordx4 v[168:171], v1, s[20:23], s54 offen offset:768 nt
    v_perm_b32 v62, v208, v204, s44
    v_perm_b32 v66, v208, v204, s45
    v_perm_b32 v70, v209, v205, s44
    v_perm_b32 v74, v209, v205, s45
    v_mfma_f32_16x16x32_bf16 a[16:19], v[44:47], a[40:43], a[16:19]
    v_perm_b32 v78, v210, v206, s44
    v_perm_b32 v82, v210, v206, s45
    v_perm_b32 v86, v211, v207, s44
    v_perm_b32 v90, v211, v207, s45
    v_mfma_f32_16x16x32_bf16 a[20:23], v[48:51], a[40:43], a[20:23]
    s_cbranch_vccz L_rxK_3_3
    s_waitcnt vmcnt(19)
L_rxK_3_3:
    s_waitcnt vmcnt(23)
    buffer_load_dwordx4 v[172:175], v1, s[20:23], s54 offen offset:1024 nt
    buffer_load_dwordx4 v[176:179], v1, s[20:23], s54 offen offset:1280 nt
    v_perm_b32 v63, v216, v212, s44
    v_perm_b32 v67, v216, v212, s45
    v_perm_b32 v71, v217, v213, s44
    v_perm_b32 v75, v217, v213, s45
    v_mfma_f32_16x16x32_bf16 a[24:27], v[52:55], a[40:43], a[24:27]
    v_perm_b32 v79, v218, v214, s44
    v_perm_b32 v83, v218, v214, s45
    v_perm_b32 v87, v219, v215, s44
    v_perm_b32 v91, v219, v215, s45
    v_mfma_f32_16x16x32_bf16 a[28:31], v[56:59], a[40:43], a[28:31]
    ds_add_u32 v11, v6
    s_add_u32 s46, s46, 1
    s_cmp_lt_u32 s46, 16
    s_cbranch_scc1 L_k
    s_cbranch_vccz L_rxVf_0_0
    s_waitcnt vmcnt(19)
L_rxVf_0_0:
    s_waitcnt vmcnt(22)
    buffer_load_dwordx4 v[180:183], v1, s[20:23], s54 offen offset:1536 nt
    buffer_load_dwordx4 v[184:187], v1, s[20:23], s54 offen offset:1792 nt
    v_accvgpr_write_b32 a40, v20
    v_accvgpr_write_b32 a41, v21
    v_accvgpr_write_b32 a42, v22
    v_accvgpr_write_b32 a43, v23
    s_or_b32 s54, s53, 65536
    s_add_u32 s54, s54, 4096
    s_and_b32 s54, s54, 454656
    s_lshr_b32 s43, s54, 7
    buffer_load_dwordx4 v[20:23], v2, s[24:27], s43 offen
    v_perm_b32 v28, v96, v92, s44
    v_perm_b32 v32, v96, v92, s45
    v_perm_b32 v36, v97, v93, s44
    v_perm_b32 v40, v97, v93, s45
    v_mfma_f32_16x16x32_bf16 a[0:3], v[60:63], a[44:47], a[0:3]
    v_perm_b32 v44, v98, v94, s44
    v_perm_b32 v48, v98, v94, s45
    v_perm_b32 v52, v99, v95, s44
    v_perm_b32 v56, v99, v95, s45
    v_mfma_f32_16x16x32_bf16 a[4:7], v[64:67], a[44:47], a[4:7]
    s_cbranch_vccz L_rxVf_0_1
    s_waitcnt vmcnt(20)
L_rxVf_0_1:
    s_waitcnt vmcnt(23)
    buffer_load_dwordx4 v[188:191], v1, s[20:23], s55 offen nt
    buffer_load_dwordx4 v[192:195], v1, s[20:23], s55 offen offset:256 nt
    v_perm_b32 v29, v104, v100, s44
    v_perm_b32 v33, v104, v100, s45
    v_perm_b32 v37, v105, v101, s44
    v_perm_b32 v41, v105, v101, s45
    v_mfma_f32_16x16x32_bf16 a[8:11], v[68:71], a[44:47], a[8:11]
    v_perm_b32 v45, v106, v102, s44
    v_perm_b32 v49, v106, v102, s45
    v_perm_b32 v53, v107, v103, s44
    v_perm_b32 v57, v107, v103, s45
    v_mfma_f32_16x16x32_bf16 a[12:15], v[72:75], a[44:47], a[12:15]
    ds_write_b128 v3, a[0:3] offset:0
    ds_write_b128 v3, a[4:7] offset:1024
    s_cbranch_vccz L_rxVf_0_2
    s_waitcnt vmcnt(19)
L_rxVf_0_2:
    s_waitcnt vmcnt(23)
    buffer_load_dwordx4 v[196:199], v1, s[20:23], s55 offen offset:512 nt
    buffer_load_dwordx4 v[200:203], v1, s[20:23], s55 offen offset:768 nt
    v_perm_b32 v30, v112, v108, s44
    v_perm_b32 v34, v112, v108, s45
    v_perm_b32 v38, v113, v109, s44
    v_perm_b32 v42, v113, v109, s45
    v_mfma_f32_16x16x32_bf16 a[16:19], v[76:79], a[44:47], a[16:19]
    v_perm_b32 v46, v114, v110, s44
    v_perm_b32 v50, v114, v110, s45
    v_perm_b32 v54, v115, v111, s44
    v_perm_b32 v58, v115, v111, s45
    v_mfma_f32_16x16x32_bf16 a[20:23], v[80:83], a[44:47], a[20:23]
    ds_write_b128 v3, a[8:11] offset:2048
    ds_write_b128 v3, a[12:15] offset:3072
    s_cbranch_vccz L_rxVf_0_3
    s_waitcnt vmcnt(19)
L_rxVf_0_3:
    s_waitcnt vmcnt(23)
    buffer_load_dwordx4 v[204:207], v1, s[20:23], s55 offen offset:1024 nt
    buffer_load_dwordx4 v[208:211], v1, s[20:23], s55 offen offset:1280 nt
    v_perm_b32 v31, v120, v116, s44
    v_perm_b32 v35, v120, v116, s45
    v_perm_b32 v39, v121, v117, s44
    v_perm_b32 v43, v121, v117, s45
    v_mfma_f32_16x16x32_bf16 a[24:27], v[84:87], a[44:47], a[24:27]
    v_perm_b32 v47, v122, v118, s44
    v_perm_b32 v51, v122, v118, s45
    v_perm_b32 v55, v123, v119, s44
    v_perm_b32 v59, v123, v119, s45
    v_mfma_f32_16x16x32_bf16 a[28:31], v[88:91], a[44:47], a[28:31]
    ds_write_b128 v3, a[16:19] offset:4096
    ds_write_b128 v3, a[20:23] offset:5120
    v_lshlrev_b32 v9, 8, v6
    s_nop 5
    ds_write_b128 v3, a[24:27] offset:6144
    ds_write_b128 v3, a[28:31] offset:7168
    ds_add_u32 v11, v9
    s_branch L_v1
L_v:
    s_cbranch_vccz L_rxV_0_0
    s_waitcnt vmcnt(19)
L_rxV_0_0:
    s_waitcnt vmcnt(22)
    buffer_load_dwordx4 v[180:183], v1, s[20:23], s54 offen offset:1536 nt
    buffer_load_dwordx4 v[184:187], v1, s[20:23], s54 offen offset:1792 nt
    v_accvgpr_write_b32 a40, v20
    v_accvgpr_write_b32 a41, v21
    v_accvgpr_write_b32 a42, v22
    v_accvgpr_write_b32 a43, v23
    s_or_b32 s54, s53, 65536
    s_add_u32 s54, s54, 4096
    s_and_b32 s54, s54, 454656
    s_lshr_b32 s43, s54, 7
    buffer_load_dwordx4 v[20:23], v2, s[24:27], s43 offen
    v_perm_b32 v28, v96, v92, s44
    v_perm_b32 v32, v96, v92, s45
    v_perm_b32 v36, v97, v93, s44
    v_perm_b32 v40, v97, v93, s45
    v_mfma_f32_16x16x32_bf16 v[220:223], a[44:47], v[60:63], v[220:223]
    v_perm_b32 v44, v98, v94, s44
    v_perm_b32 v48, v98, v94, s45
    v_perm_b32 v52, v99, v95, s44
    v_perm_b32 v56, v99, v95, s45
    v_mfma_f32_16x16x32_bf16 v[224:227], a[44:47], v[64:67], v[224:227]
    s_cbranch_vccz L_rxV_0_1
    s_waitcnt vmcnt(20)
L_rxV_0_1:
    s_waitcnt vmcnt(23)
    buffer_load_dwordx4 v[188:191], v1, s[20:23], s55 offen nt
    buffer_load_dwordx4 v[192:195], v1, s[20:23], s55 offen offset:256 nt
    v_perm_b32 v29, v104, v100, s44
    v_perm_b32 v33, v104, v100, s45
    v_perm_b32 v37, v105, v101, s44
    v_perm_b32 v41, v105, v101, s45
    v_mfma_f32_16x16x32_bf16 v[228:231], a[44:47], v[68:71], v[228:231]
    v_perm_b32 v45, v106, v102, s44
    v_perm_b32 v49, v106, v102, s45
    v_perm_b32 v53, v107, v103, s44
    v_perm_b32 v57, v107, v103, s45
    v_mfma_f32_16x16x32_bf16 v[232:235], a[44:47], v[72:75], v[232:235]
    s_cbranch_vccz L_rxV_0_2
    s_waitcnt vmcnt(19)
L_rxV_0_2:
    s_waitcnt vmcnt(23)
    buffer_load_dwordx4 v[196:199], v1, s[20:23], s55 offen offset:512 nt
    buffer_load_dwordx4 v[200:203], v1, s[20:23], s55 offen offset:768 nt
    v_perm_b32 v30, v112, v108, s44
    v_perm_b32 v34, v112, v108, s45
    v_perm_b32 v38, v113, v109, s44
    v_perm_b32 v42, v113, v109, s45
    v_mfma_f32_16x16x32_bf16 v[236:239], a[44:47], v[76:79], v[236:239]
    v_perm_b32 v46, v114, v110, s44
    v_perm_b32 v50, v114, v110, s45
    v_perm_b32 v54, v115, v111, s44
    v_perm_b32 v58, v115, v111, s45
    v_mfma_f32_16x16x32_bf16 v[240:243], a[44:47], v[80:83], v[240:243]
    s_cbranch_vccz L_rxV_0_3
    s_waitcnt vmcnt(19)
L_rxV_0_3:
    s_waitcnt vmcnt(23)
    buffer_load_dwordx4 v[204:207], v1, s[20:23], s55 offen offset:1024 nt
    buffer_load_dwordx4 v[208:211], v1, s[20:23], s55 offen offset:1280 nt
    v_perm_b32 v31, v120, v116, s44
    v_perm_b32 v35, v120, v116, s45
    v_perm_b32 v39, v121, v117, s44
    v_perm_b32 v43, v121, v117, s45
    v_mfma_f32_16x16x32_bf16 v[244:247], a[44:47], v[84:87], v[244:247]
    v_perm_b32 v47, v122, v118, s44
    v_perm_b32 v51, v122, v118, s45
    v_perm_b32 v55, v123, v119, s44
    v_perm_b32 v59, v123, v119, s45
    v_mfma_f32_16x16x32_bf16 v[248:251], a[44:47], v[88:91], v[248:251]
L_v1:
    s_cbranch_vccz L_rxV_1_0
    s_waitcnt vmcnt(19)
L_rxV_1_0:
    s_waitcnt vmcnt(22)
    buffer_load_dwordx4 v[212:215], v1, s[20:23], s55 offen offset:1536 nt
    buffer_load_dwordx4 v[216:219], v1, s[20:23], s55 offen offset:1792 nt
    v_accvgpr_write_b32 a44, v24
    v_accvgpr_write_b32 a45, v25
    v_accvgpr_write_b32 a46, v26
    v_accvgpr_write_b32 a47, v27
    s_or_b32 s55, s54, 65536
    s_add_u32 s55, s55, 4096
    s_and_b32 s55, s55, 454656
    s_lshr_b32 s43, s55, 7
    buffer_load_dwordx4 v[24:27], v2, s[24:27], s43 offen
    v_perm_b32 v60, v128, v124, s44
    v_perm_b32 v64, v128, v124, s45
    v_perm_b32 v68, v129, v125, s44
    v_perm_b32 v72, v129, v125, s45
    v_mfma_f32_16x16x32_bf16 v[220:223], a[32:35], v[28:31], v[220:223]
    v_perm_b32 v76, v130, v126, s44
    v_perm_b32 v80, v130, v126, s45
    v_perm_b32 v84, v131, v127, s44
    v_perm_b32 v88, v131, v127, s45
    v_mfma_f32_16x16x32_bf16 v[224:227], a[32:35], v[32:35], v[224:227]
    s_cbranch_vccz L_rxV_1_1
    s_waitcnt vmcnt(20)
L_rxV_1_1:
    s_waitcnt vmcnt(23)
    buffer_load_dwordx4 v[92:95], v1, s[20:23], s52 offen nt
    buffer_load_dwordx4 v[96:99], v1, s[20:23], s52 offen offset:256 nt
    v_perm_b32 v61, v136, v132, s44
    v_perm_b32 v65, v136, v132, s45
    v_perm_b32 v69, v137, v133, s44
    v_perm_b32 v73, v137, v133, s45
    v_mfma_f32_16x16x32_bf16 v[228:231], a[32:35], v[36:39], v[228:231]
    v_perm_b32 v77, v138, v134, s44
    v_perm_b32 v81, v138, v134, s45
    v_perm_b32 v85, v139, v135, s44
    v_perm_b32 v89, v139, v135, s45
    v_mfma_f32_16x16x32_bf16 v[232:235], a[32:35], v[40:43], v[232:235]
    s_cbranch_vccz L_rxV_1_2
    s_waitcnt vmcnt(19)
L_rxV_1_2:
    s_waitcnt vmcnt(23)
    buffer_load_dwordx4 v[100:103], v1, s[20:23], s52 offen offset:512 nt
    buffer_load_dwordx4 v[104:107], v1, s[20:23], s52 offen offset:768 nt
    v_perm_b32 v62, v144, v140, s44
    v_perm_b32 v66, v144, v140, s45
    v_perm_b32 v70, v145, v141, s44
    v_perm_b32 v74, v145, v141, s45
    v_mfma_f32_16x16x32_bf16 v[236:239], a[32:35], v[44:47], v[236:239]
    v_perm_b32 v78, v146, v142, s44
    v_perm_b32 v82, v146, v142, s45
    v_perm_b32 v86, v147, v143, s44
    v_perm_b32 v90, v147, v143, s45
    v_mfma_f32_16x16x32_bf16 v[240:243], a[32:35], v[48:51], v[240:243]
    ds_read_b32 v10, v5 offset:4
    s_cbranch_vccz L_rxV_1_3
    s_waitcnt vmcnt(19)
L_rxV_1_3:
    s_waitcnt vmcnt(23)
    buffer_load_dwordx4 v[108:111], v1, s[20:23], s52 offen offset:1024 nt
    buffer_load_dwordx4 v[112:115], v1, s[20:23], s52 offen offset:1280 nt
    v_perm_b32 v63, v152, v148, s44
    v_perm_b32 v67, v152, v148, s45
    v_perm_b32 v71, v153, v149, s44
    v_perm_b32 v75, v153, v149, s45
    v_mfma_f32_16x16x32_bf16 v[244:247], a[32:35], v[52:55], v[244:247]
    v_perm_b32 v79, v154, v150, s44
    v_perm_b32 v83, v154, v150, s45
    v_perm_b32 v87, v155, v151, s44
    v_perm_b32 v91, v155, v151, s45
    v_mfma_f32_16x16x32_bf16 v[248:251], a[32:35], v[56:59], v[248:251]
    s_waitcnt lgkmcnt(0)
    v_cmp_ne_u32 vcc, 0, v10
    s_cbranch_vccz L_rxV_2_0
    s_waitcnt vmcnt(19)
L_rxV_2_0:
    s_waitcnt vmcnt(22)
    buffer_load_dwordx4 v[116:119], v1, s[20:23], s52 offen offset:1536 nt
    buffer_load_dwordx4 v[120:123], v1, s[20:23], s52 offen offset:1792 nt
    v_accvgpr_write_b32 a32, v12
    v_accvgpr_write_b32 a33, v13
    v_accvgpr_write_b32 a34, v14
    v_accvgpr_write_b32 a35, v15
    s_or_b32 s52, s55, 65536
    s_add_u32 s52, s52, 4096
    s_and_b32 s52, s52, 454656
    s_lshr_b32 s43, s52, 7
    buffer_load_dwordx4 v[12:15], v2, s[24:27], s43 offen
    v_perm_b32 v28, v160, v156, s44
    v_perm_b32 v32, v160, v156, s45
    v_perm_b32 v36, v161, v157, s44
    v_perm_b32 v40, v161, v157, s45
    v_mfma_f32_16x16x32_bf16 v[220:223], a[36:39], v[60:63], v[220:223]
    v_perm_b32 v44, v162, v158, s44
    v_perm_b32 v48, v162, v158, s45
    v_perm_b32 v52, v163, v159, s44
    v_perm_b32 v56, v163, v159, s45
    v_mfma_f32_16x16x32_bf16 v[224:227], a[36:39], v[64:67], v[224:227]
    s_cbranch_vccz L_rxV_2_1
    s_waitcnt vmcnt(20)
L_rxV_2_1:
    s_waitcnt vmcnt(23)
    buffer_load_dwordx4 v[124:127], v1, s[20:23], s53 offen nt
    buffer_load_dwordx4 v[128:131], v1, s[20:23], s53 offen offset:256 nt
    v_perm_b32 v29, v168, v164, s44
    v_perm_b32 v33, v168, v164, s45
    v_perm_b32 v37, v169, v165, s44
    v_perm_b32 v41, v169, v165, s45
    v_mfma_f32_16x16x32_bf16 v[228:231], a[36:39], v[68:71], v[228:231]
    v_perm_b32 v45, v170, v166, s44
    v_perm_b32 v49, v170, v166, s45
    v_perm_b32 v53, v171, v167, s44
    v_perm_b32 v57, v171, v167, s45
    v_mfma_f32_16x16x32_bf16 v[232:235], a[36:39], v[72:75], v[232:235]
    s_cbranch_vccz L_rxV_2_2
    s_waitcnt vmcnt(19)
L_rxV_2_2:
    s_waitcnt vmcnt(23)
    buffer_load_dwordx4 v[132:135], v1, s[20:23], s53 offen offset:512 nt
    buffer_load_dwordx4 v[136:139], v1, s[20:23], s53 offen offset:768 nt
    v_perm_b32 v30, v176, v172, s44
    v_perm_b32 v34, v176, v172, s45
    v_perm_b32 v38, v177, v173, s44
    v_perm_b32 v42, v177, v173, s45
    v_mfma_f32_16x16x32_bf16 v[236:239], a[36:39], v[76:79], v[236:239]
    v_perm_b32 v46, v178, v174, s44
    v_perm_b32 v50, v178, v174, s45
    v_perm_b32 v54, v179, v175, s44
    v_perm_b32 v58, v179, v175, s45
    v_mfma_f32_16x16x32_bf16 v[240:243], a[36:39], v[80:83], v[240:243]
    s_cbranch_vccz L_rxV_2_3
    s_waitcnt vmcnt(19)
L_rxV_2_3:
    s_waitcnt vmcnt(23)
    buffer_load_dwordx4 v[140:143], v1, s[20:23], s53 offen offset:1024 nt
    buffer_load_dwordx4 v[144:147], v1, s[20:23], s53 offen offset:1280 nt
    v_perm_b32 v31, v184, v180, s44
    v_perm_b32 v35, v184, v180, s45
    v_perm_b32 v39, v185, v181, s44
    v_perm_b32 v43, v185, v181, s45
    v_mfma_f32_16x16x32_bf16 v[244:247], a[36:39], v[84:87], v[244:247]
    v_perm_b32 v47, v186, v182, s44
    v_perm_b32 v51, v186, v182, s45
    v_perm_b32 v55, v187, v183, s44
    v_perm_b32 v59, v187, v183, s45
    v_mfma_f32_16x16x32_bf16 v[248:251], a[36:39], v[88:91], v[248:251]
    s_cbranch_vccz L_rxV_3_0
    s_waitcnt vmcnt(19)
L_rxV_3_0:
    s_waitcnt vmcnt(22)
    buffer_load_dwordx4 v[148:151], v1, s[20:23], s53 offen offset:1536 nt
    buffer_load_dwordx4 v[152:155], v1, s[20:23], s53 offen offset:1792 nt
    v_accvgpr_write_b32 a36, v16
    v_accvgpr_write_b32 a37, v17
    v_accvgpr_write_b32 a38, v18
    v_accvgpr_write_b32 a39, v19
    s_or_b32 s53, s52, 65536
    s_add_u32 s53, s53, 4096
    s_and_b32 s53, s53, 454656
    s_lshr_b32 s43, s53, 7
    buffer_load_dwordx4 v[16:19], v2, s[24:27], s43 offen
    v_perm_b32 v60, v192, v188, s44
    v_perm_b32 v64, v192, v188, s45
    v_perm_b32 v68, v193, v189, s44
    v_perm_b32 v72, v193, v189, s45
    v_mfma_f32_16x16x32_bf16 v[220:223], a[40:43], v[28:31], v[220:223]
    v_perm_b32 v76, v194, v190, s44
    v_perm_b32 v80, v194, v190, s45
    v_perm_b32 v84, v195, v191, s44
    v_perm_b32 v88, v195, v191, s45
    v_mfma_f32_16x16x32_bf16 v[224:227], a[40:43], v[32:35], v[224:227]
    s_cbranch_vccz L_rxV_3_1
    s_waitcnt vmcnt(20)
L_rxV_3_1:
    s_waitcnt vmcnt(23)
    buffer_load_dwordx4 v[156:159], v1, s[20:23], s54 offen nt
    buffer_load_dwordx4 v[160:163], v1, s[20:23], s54 offen offset:256 nt
    v_perm_b32 v61, v200, v196, s44
    v_perm_b32 v65, v200, v196, s45
    v_perm_b32 v69, v201, v197, s44
    v_perm_b32 v73, v201, v197, s45
    v_mfma_f32_16x16x32_bf16 v[228:231], a[40:43], v[36:39], v[228:231]
    v_perm_b32 v77, v202, v198, s44
    v_perm_b32 v81, v202, v198, s45
    v_perm_b32 v85, v203, v199, s44
    v_perm_b32 v89, v203, v199, s45
    v_mfma_f32_16x16x32_bf16 v[232:235], a[40:43], v[40:43], v[232:235]
    s_cbranch_vccz L_rxV_3_2
    s_waitcnt vmcnt(19)
L_rxV_3_2:
    s_waitcnt vmcnt(23)
    buffer_load_dwordx4 v[164:167], v1, s[20:23], s54 offen offset:512 nt
    buffer_load_dwordx4 v[168:171], v1, s[20:23], s54 offen offset:768 nt
    v_perm_b32 v62, v208, v204, s44
    v_perm_b32 v66, v208, v204, s45
    v_perm_b32 v70, v209, v205, s44
    v_perm_b32 v74, v209, v205, s45
    v_mfma_f32_16x16x32_bf16 v[236:239], a[40:43], v[44:47], v[236:239]
    v_perm_b32 v78, v210, v206, s44
    v_perm_b32 v82, v210, v206, s45
    v_perm_b32 v86, v211, v207, s44
    v_perm_b32 v90, v211, v207, s45
    v_mfma_f32_16x16x32_bf16 v[240:243], a[40:43], v[48:51], v[240:243]
    s_cbranch_vccz L_rxV_3_3
    s_waitcnt vmcnt(19)
L_rxV_3_3:
    s_waitcnt vmcnt(23)
    buffer_load_dwordx4 v[172:175], v1, s[20:23], s54 offen offset:1024 nt
    buffer_load_dwordx4 v[176:179], v1, s[20:23], s54 offen offset:1280 nt
    v_perm_b32 v63, v216, v212, s44
    v_perm_b32 v67, v216, v212, s45
    v_perm_b32 v71, v217, v213, s44
    v_perm_b32 v75, v217, v213, s45
    v_mfma_f32_16x16x32_bf16 v[244:247], a[40:43], v[52:55], v[244:247]
    v_perm_b32 v79, v218, v214, s44
    v_perm_b32 v83, v218, v214, s45
    v_perm_b32 v87, v219, v215, s44
    v_perm_b32 v91, v219, v215, s45
    v_mfma_f32_16x16x32_bf16 v[248:251], a[40:43], v[56:59], v[248:251]
    ds_add_u32 v11, v6
    s_add_u32 s46, s46, 1
    s_cmp_lt_u32 s46, 31
    s_cbranch_scc1 L_v
    buffer_load_dwordx4 v[180:183], v1, s[20:23], s54 offen offset:1536 nt
    buffer_load_dwordx4 v[184:187], v1, s[20:23], s54 offen offset:1792 nt
    buffer_load_dwordx4 v[188:191], v1, s[20:23], s55 offen nt
    buffer_load_dwordx4 v[192:195], v1, s[20:23], s55 offen offset:256 nt
    buffer_load_dwordx4 v[196:199], v1, s[20:23], s55 offen offset:512 nt
    buffer_load_dwordx4 v[200:203], v1, s[20:23], s55 offen offset:768 nt
    buffer_load_dwordx4 v[204:207], v1, s[20:23], s55 offen offset:1024 nt
    buffer_load_dwordx4 v[208:211], v1, s[20:23], s55 offen offset:1280 nt
    buffer_load_dwordx4 v[212:215], v1, s[20:23], s55 offen offset:1536 nt
    buffer_load_dwordx4 v[216:219], v1, s[20:23], s55 offen offset:1792 nt
    s_waitcnt vmcnt(32)
    v_accvgpr_write_b32 a40, v20
    v_accvgpr_write_b32 a41, v21
    v_accvgpr_write_b32 a42, v22
    v_accvgpr_write_b32 a43, v23
    v_perm_b32 v28, v96, v92, s44
    v_perm_b32 v32, v96, v92, s45
    v_perm_b32 v36, v97, v93, s44
    v_perm_b32 v40, v97, v93, s45
    v_mfma_f32_16x16x32_bf16 v[220:223], a[44:47], v[60:63], v[220:223]
    v_perm_b32 v44, v98, v94, s44
    v_perm_b32 v48, v98, v94, s45
    v_perm_b32 v52, v99, v95, s44
    v_perm_b32 v56, v99, v95, s45
    v_mfma_f32_16x16x32_bf16 v[224:227], a[44:47], v[64:67], v[224:227]
    s_waitcnt vmcnt(30)
    v_perm_b32 v29, v104, v100, s44
    v_perm_b32 v33, v104, v100, s45
    v_perm_b32 v37, v105, v101, s44
    v_perm_b32 v41, v105, v101, s45
    v_mfma_f32_16x16x32_bf16 v[228:231], a[44:47], v[68:71], v[228:231]
    v_perm_b32 v45, v106, v102, s44
    v_perm_b32 v49, v106, v102, s45
    v_perm_b32 v53, v107, v103, s44
    v_perm_b32 v57, v107, v103, s45
    v_mfma_f32_16x16x32_bf16 v[232:235], a[44:47], v[72:75], v[232:235]
    s_waitcnt vmcnt(28)
    v_perm_b32 v30, v112, v108, s44
    v_perm_b32 v34, v112, v108, s45
    v_perm_b32 v38, v113, v109, s44
    v_perm_b32 v42, v113, v109, s45
    v_mfma_f32_16x16x32_bf16 v[236:239], a[44:47], v[76:79], v[236:239]
    v_perm_b32 v46, v114, v110, s44
    v_perm_b32 v50, v114, v110, s45
    v_perm_b32 v54, v115, v111, s44
    v_perm_b32 v58, v115, v111, s45
    v_mfma_f32_16x16x32_bf16 v[240:243], a[44:47], v[80:83], v[240:243]
    s_waitcnt vmcnt(26)
    v_perm_b32 v31, v120, v116, s44
    v_perm_b32 v35, v120, v116, s45
    v_perm_b32 v39, v121, v117, s44
    v_perm_b32 v43, v121, v117, s45
    v_mfma_f32_16x16x32_bf16 v[244:247], a[44:47], v[84:87], v[244:247]
    v_perm_b32 v47, v122, v118, s44
    v_perm_b32 v51, v122, v118, s45
    v_perm_b32 v55, v123, v119, s44
    v_perm_b32 v59, v123, v119, s45
    v_mfma_f32_16x16x32_bf16 v[248:251], a[44:47], v[88:91], v[248:251]
    s_waitcnt vmcnt(23)
    v_accvgpr_write_b32 a44, v24
    v_accvgpr_write_b32 a45, v25
    v_accvgpr_write_b32 a46, v26
    v_accvgpr_write_b32 a47, v27
    v_perm_b32 v60, v128, v124, s44
    v_perm_b32 v64, v128, v124, s45
    v_perm_b32 v68, v129, v125, s44
    v_perm_b32 v72, v129, v125, s45
    v_mfma_f32_16x16x32_bf16 v[220:223], a[32:35], v[28:31], v[220:223]
    v_perm_b32 v76, v130, v126, s44
    v_perm_b32 v80, v130, v126, s45
    v_perm_b32 v84, v131, v127, s44
    v_perm_b32 v88, v131, v127, s45
    v_mfma_f32_16x16x32_bf16 v[224:227], a[32:35], v[32:35], v[224:227]
    s_waitcnt vmcnt(21)
    v_perm_b32 v61, v136, v132, s44
    v_perm_b32 v65, v136, v132, s45
    v_perm_b32 v69, v137, v133, s44
    v_perm_b32 v73, v137, v133, s45
    v_mfma_f32_16x16x32_bf16 v[228:231], a[32:35], v[36:39], v[228:231]
    v_perm_b32 v77, v138, v134, s44
    v_perm_b32 v81, v138, v134, s45
    v_perm_b32 v85, v139, v135, s44
    v_perm_b32 v89, v139, v135, s45
    v_mfma_f32_16x16x32_bf16 v[232:235], a[32:35], v[40:43], v[232:235]
    s_waitcnt vmcnt(19)
    v_perm_b32 v62, v144, v140, s44
    v_perm_b32 v66, v144, v140, s45
    v_perm_b32 v70, v145, v141, s44
    v_perm_b32 v74, v145, v141, s45
    v_mfma_f32_16x16x32_bf16 v[236:239], a[32:35], v[44:47], v[236:239]
    v_perm_b32 v78, v146, v142, s44
    v_perm_b32 v82, v146, v142, s45
    v_perm_b32 v86, v147, v143, s44
    v_perm_b32 v90, v147, v143, s45
    v_mfma_f32_16x16x32_bf16 v[240:243], a[32:35], v[48:51], v[240:243]
    s_waitcnt vmcnt(17)
    v_perm_b32 v63, v152, v148, s44
    v_perm_b32 v67, v152, v148, s45
    v_perm_b32 v71, v153, v149, s44
    v_perm_b32 v75, v153, v149, s45
    v_mfma_f32_16x16x32_bf16 v[244:247], a[32:35], v[52:55], v[244:247]
    v_perm_b32 v79, v154, v150, s44
    v_perm_b32 v83, v154, v150, s45
    v_perm_b32 v87, v155, v151, s44
    v_perm_b32 v91, v155, v151, s45
    v_mfma_f32_16x16x32_bf16 v[248:251], a[32:35], v[56:59], v[248:251]
    s_waitcnt vmcnt(14)
    s_barrier
    ds_read_b64 v[8:9], v4 offset:8192
    v_perm_b32 v28, v160, v156, s44
    v_perm_b32 v32, v160, v156, s45
    v_perm_b32 v36, v161, v157, s44
    v_perm_b32 v40, v161, v157, s45
    v_mfma_f32_16x16x32_bf16 v[220:223], a[36:39], v[60:63], v[220:223]
    v_perm_b32 v44, v162, v158, s44
    v_perm_b32 v48, v162, v158, s45
    v_perm_b32 v52, v163, v159, s44
    v_perm_b32 v56, v163, v159, s45
    v_mfma_f32_16x16x32_bf16 v[224:227], a[36:39], v[64:67], v[224:227]
    s_waitcnt vmcnt(12)
    v_perm_b32 v29, v168, v164, s44
    v_perm_b32 v33, v168, v164, s45
    v_perm_b32 v37, v169, v165, s44
    v_perm_b32 v41, v169, v165, s45
    v_mfma_f32_16x16x32_bf16 v[228:231], a[36:39], v[68:71], v[228:231]
    v_perm_b32 v45, v170, v166, s44
    v_perm_b32 v49, v170, v166, s45
    v_perm_b32 v53, v171, v167, s44
    v_perm_b32 v57, v171, v167, s45
    v_mfma_f32_16x16x32_bf16 v[232:235], a[36:39], v[72:75], v[232:235]
    s_waitcnt vmcnt(10)
    v_perm_b32 v30, v176, v172, s44
    v_perm_b32 v34, v176, v172, s45
    v_perm_b32 v38, v177, v173, s44
    v_perm_b32 v42, v177, v173, s45
    v_mfma_f32_16x16x32_bf16 v[236:239], a[36:39], v[76:79], v[236:239]
    v_perm_b32 v46, v178, v174, s44
    v_perm_b32 v50, v178, v174, s45
    v_perm_b32 v54, v179, v175, s44
    v_perm_b32 v58, v179, v175, s45
    v_mfma_f32_16x16x32_bf16 v[240:243], a[36:39], v[80:83], v[240:243]
    s_waitcnt vmcnt(8)
    v_perm_b32 v31, v184, v180, s44
    v_perm_b32 v35, v184, v180, s45
    v_perm_b32 v39, v185, v181, s44
    v_perm_b32 v43, v185, v181, s45
    v_mfma_f32_16x16x32_bf16 v[244:247], a[36:39], v[84:87], v[244:247]
    v_perm_b32 v47, v186, v182, s44
    v_perm_b32 v51, v186, v182, s45
    v_perm_b32 v55, v187, v183, s44
    v_perm_b32 v59, v187, v183, s45
    v_mfma_f32_16x16x32_bf16 v[248:251], a[36:39], v[88:91], v[248:251]
    s_waitcnt vmcnt(6)
    v_perm_b32 v60, v192, v188, s44
    v_perm_b32 v64, v192, v188, s45
    v_perm_b32 v68, v193, v189, s44
    v_mfma_f32_16x16x32_bf16 v[220:223], a[40:43], v[28:31], v[220:223]
    v_perm_b32 v72, v193, v189, s45
    v_perm_b32 v76, v194, v190, s44
    v_perm_b32 v80, v194, v190, s45
    v_mfma_f32_16x16x32_bf16 v[224:227], a[40:43], v[32:35], v[224:227]
    v_perm_b32 v84, v195, v191, s44
    v_perm_b32 v88, v195, v191, s45
    v_mfma_f32_16x16x32_bf16 v[228:231], a[40:43], v[36:39], v[228:231]
    s_waitcnt vmcnt(4)
    v_perm_b32 v61, v200, v196, s44
    v_perm_b32 v65, v200, v196, s45
    v_perm_b32 v69, v201, v197, s44
    v_mfma_f32_16x16x32_bf16 v[232:235], a[40:43], v[40:43], v[232:235]
    v_perm_b32 v73, v201, v197, s45
    v_perm_b32 v77, v202, v198, s44
    v_perm_b32 v81, v202, v198, s45
    v_mfma_f32_16x16x32_bf16 v[236:239], a[40:43], v[44:47], v[236:239]
    v_perm_b32 v85, v203, v199, s44
    v_perm_b32 v89, v203, v199, s45
    v_mfma_f32_16x16x32_bf16 v[240:243], a[40:43], v[48:51], v[240:243]
    s_waitcnt vmcnt(2)
    v_perm_b32 v62, v208, v204, s44
    v_perm_b32 v66, v208, v204, s45
    v_perm_b32 v70, v209, v205, s44
    v_mfma_f32_16x16x32_bf16 v[244:247], a[40:43], v[52:55], v[244:247]
    v_perm_b32 v74, v209, v205, s45
    v_perm_b32 v78, v210, v206, s44
    v_perm_b32 v82, v210, v206, s45
    v_mfma_f32_16x16x32_bf16 v[248:251], a[40:43], v[56:59], v[248:251]
    v_perm_b32 v86, v211, v207, s44
    v_perm_b32 v90, v211, v207, s45
    s_waitcnt vmcnt(0)
    v_perm_b32 v63, v216, v212, s44
    v_perm_b32 v67, v216, v212, s45
    v_perm_b32 v71, v217, v213, s44
    v_mfma_f32_16x16x32_bf16 v[220:223], a[44:47], v[60:63], v[220:223]
    v_perm_b32 v75, v217, v213, s45
    v_mfma_f32_16x16x32_bf16 v[224:227], a[44:47], v[64:67], v[224:227]
    v_perm_b32 v79, v218, v214, s44
    v_mfma_f32_16x16x32_bf16 v[228:231], a[44:47], v[68:71], v[228:231]
    v_perm_b32 v83, v218, v214, s45
    v_mfma_f32_16x16x32_bf16 v[232:235], a[44:47], v[72:75], v[232:235]
    v_perm_b32 v87, v219, v215, s44
    v_mfma_f32_16x16x32_bf16 v[236:239], a[44:47], v[76:79], v[236:239]
    v_perm_b32 v91, v219, v215, s45
    v_mfma_f32_16x16x32_bf16 v[240:243], a[44:47], v[80:83], v[240:243]
    s_waitcnt lgkmcnt(0)
    v_mfma_f32_16x16x32_bf16 v[244:247], a[44:47], v[84:87], v[244:247]
    v_mfma_f32_16x16x32_bf16 v[248:251], a[44:47], v[88:91], v[248:251]
    v_cvt_pk_bf16_f32 v28, v220, v221
    v_cvt_pk_bf16_f32 v29, v222, v223
    v_cvt_pk_bf16_f32 v30, v224, v225
    v_cvt_pk_bf16_f32 v31, v226, v227
    v_mfma_f32_16x16x16_bf16 v[220:223], v[8:9], v[28:29], 0
    v_cvt_pk_bf16_f32 v32, v228, v229
    v_cvt_pk_bf16_f32 v33, v230, v231
    v_mfma_f32_16x16x16_bf16 v[224:227], v[8:9], v[30:31], 0
    v_cvt_pk_bf16_f32 v34, v232, v233
    v_cvt_pk_bf16_f32 v35, v234, v235
    v_mfma_f32_16x16x16_bf16 v[228:231], v[8:9], v[32:33], 0
    v_cvt_pk_bf16_f32 v36, v236, v237
    v_cvt_pk_bf16_f32 v37, v238, v239
    v_mfma_f32_16x16x16_bf16 v[232:235], v[8:9], v[34:35], 0
    v_cvt_pk_bf16_f32 v38, v240, v241
    v_cvt_pk_bf16_f32 v39, v242, v243
    v_mfma_f32_16x16x16_bf16 v[236:239], v[8:9], v[36:37], 0
    v_cvt_pk_bf16_f32 v40, v244, v245
    v_cvt_pk_bf16_f32 v41, v246, v247
    v_mfma_f32_16x16x16_bf16 v[240:243], v[8:9], v[38:39], 0
    v_cvt_pk_bf16_f32 v42, v248, v249
    v_cvt_pk_bf16_f32 v43, v250, v251
    v_mfma_f32_16x16x16_bf16 v[244:247], v[8:9], v[40:41], 0
    s_nop 1
    v_mfma_f32_16x16x16_bf16 v[248:251], v[8:9], v[42:43], 0
    v_cvt_pk_bf16_f32 v44, v220, v224
    v_cvt_pk_bf16_f32 v45, v228, v232
    s_nop 0
    v_cvt_pk_bf16_f32 v46, v236, v240
    s_nop 3
    v_cvt_pk_bf16_f32 v47, v244, v248
    buffer_store_dwordx4 v[44:47], v3, s[36:39], 0 offen
    s_endpgm
L_helper:
    s_mov_b32 s28, s16
    s_mov_b32 s29, s17
    s_mov_b32 s30, 256
    s_mov_b32 s31, 0x20000
    s_and_b32 s56, s2, 7
    s_lshl_b32 s56, s56, 5
    s_lshr_b32 s57, s2, 3
    s_add_u32 s58, s56, s57
    v_mov_b32 v97, 0x1000
    v_add_u32 v96, s56, v0
    v_cmp_gt_u32 vcc, 32, v0
    s_add_u32 s32, s4, s48
    s_addc_u32 s33, s5, 0
    v_cndmask_b32 v96, v97, v96, vcc
    v_writelane_b32 v97, s58, 0
    s_mov_b32 s34, 0x400
    s_mov_b32 s35, 0x20000
    v_lshrrev_b32 v14, 2, v10
    v_lshlrev_b32 v14, 8, v14
    v_lshl_add_u32 v14, v11, 6, v14
    buffer_load_ubyte v98, v96, s[28:31], 0 offen nt
    buffer_load_dwordx4 v[16:19], v14, s[32:35], 0 offen
    buffer_load_dwordx4 v[20:23], v14, s[32:35], 0 offen offset:16
    buffer_load_dwordx4 v[24:27], v14, s[32:35], 0 offen offset:32
    buffer_load_dwordx4 v[28:31], v14, s[32:35], 0 offen offset:48
    s_mov_b32 s62, 0x3db504f3
    s_mov_b32 s63, 0x3fb8aa3b
    s_mov_b32 s70, 0
L_hpoll:
    ds_read_b32 v12, v5
    s_waitcnt lgkmcnt(0)
    v_readfirstlane_b32 s74, v12
    s_xor_b32 s75, s74, s70
    s_cbranch_scc1 L_hchg
    s_sleep 1
    s_branch L_hpoll
L_hchg:
    s_mov_b32 s70, s74
    s_and_b32 s74, s74, 0xff
    s_and_b32 s76, s75, 0xff
    s_cbranch_scc0 L_hsm
    s_cmp_ge_u32 s74, 31
    s_cbranch_scc1 L_hfin
    v_mov_b32 v99, s74
    buffer_load_ubyte v98, v96, s[28:31], 0 offen nt
    buffer_store_byte v99, v97, s[28:31], 0 offen
    s_waitcnt vmcnt(1)
    v_cmp_le_u32 vcc, s74, v98
    s_nop 0
    s_bcnt1_i32_b64 s78, vcc
    s_cmp_lt_i32 s78, 25
    s_cselect_b32 s78, 1, 0
    v_mov_b32 v13, s78
    ds_write_b32 v5, v13 offset:4
    s_bitcmp1_b32 s75, 8
    s_cbranch_scc0 L_hpoll
L_hsm:
    ds_read_b128 v[48:51], v3 offset:0
    ds_read_b128 v[52:55], v3 offset:1024
    ds_read_b128 v[56:59], v3 offset:2048
    ds_read_b128 v[60:63], v3 offset:3072
    ds_read_b128 v[64:67], v3 offset:4096
    ds_read_b128 v[68:71], v3 offset:5120
    ds_read_b128 v[72:75], v3 offset:6144
    ds_read_b128 v[76:79], v3 offset:7168
    s_waitcnt lgkmcnt(0)
    v_cvt_pk_bf16_f32 v32, v48, v52
    v_cvt_pk_bf16_f32 v36, v49, v53
    v_cvt_pk_bf16_f32 v40, v50, v54
    v_cvt_pk_bf16_f32 v44, v51, v55
    v_cvt_pk_bf16_f32 v33, v56, v60
    v_cvt_pk_bf16_f32 v37, v57, v61
    v_cvt_pk_bf16_f32 v41, v58, v62
    v_cvt_pk_bf16_f32 v45, v59, v63
    v_cvt_pk_bf16_f32 v34, v64, v68
    v_cvt_pk_bf16_f32 v38, v65, v69
    v_cvt_pk_bf16_f32 v42, v66, v70
    v_cvt_pk_bf16_f32 v46, v67, v71
    v_cvt_pk_bf16_f32 v35, v72, v76
    v_cvt_pk_bf16_f32 v39, v73, v77
    v_cvt_pk_bf16_f32 v43, v74, v78
    v_cvt_pk_bf16_f32 v47, v75, v79
    s_waitcnt vmcnt(0)
    s_nop 0
    v_mfma_f32_16x16x32_bf16 v[80:83], v[32:35], v[16:19], 0
    v_mfma_f32_16x16x32_bf16 v[80:83], v[36:39], v[20:23], v[80:83]
    v_mfma_f32_16x16x32_bf16 v[80:83], v[40:43], v[24:27], v[80:83]
    v_mfma_f32_16x16x32_bf16 v[80:83], v[44:47], v[28:31], v[80:83]
    s_nop 7
    v_cvt_pk_bf16_f32 v84, v80, v81
    v_cvt_pk_bf16_f32 v85, v82, v83
    v_lshlrev_b32 v80, 16, v84
    v_and_b32 v81, 0xffff0000, v84
    v_lshlrev_b32 v82, 16, v85
    v_and_b32 v83, 0xffff0000, v85
    v_mul_f32 v80, s62, v80
    v_mul_f32 v81, s62, v81
    v_mul_f32 v82, s62, v82
    v_mul_f32 v83, s62, v83
    v_cvt_pk_bf16_f32 v84, v80, v81
    v_cvt_pk_bf16_f32 v85, v82, v83
    v_lshlrev_b32 v80, 16, v84
    v_and_b32 v81, 0xffff0000, v84
    v_lshlrev_b32 v82, 16, v85
    v_and_b32 v83, 0xffff0000, v85
    v_max_f32 v88, v80, v81
    v_max3_f32 v88, v82, v83, v88
    v_mov_b32 v89, v88
    s_nop 1
    v_permlane32_swap_b32 v88, v89
    s_nop 1
    v_max_f32 v88, v88, v89
    v_mov_b32 v89, v88
    s_nop 1
    v_permlane16_swap_b32 v88, v89
    s_nop 1
    v_max_f32 v88, v88, v89
    v_sub_f32 v80, v80, v88
    v_sub_f32 v81, v81, v88
    v_sub_f32 v82, v82, v88
    v_sub_f32 v83, v83, v88
    v_mul_f32 v80, s63, v80
    v_mul_f32 v81, s63, v81
    v_mul_f32 v82, s63, v82
    v_mul_f32 v83, s63, v83
    v_exp_f32 v80, v80
    v_exp_f32 v81, v81
    v_exp_f32 v82, v82
    v_exp_f32 v83, v83
    s_nop 0
    v_add_f32 v88, v80, v81
    v_add_f32 v90, v82, v83
    v_add_f32 v88, v88, v90
    v_mov_b32 v89, v88
    s_nop 1
    v_permlane32_swap_b32 v88, v89
    s_nop 1
    v_add_f32 v88, v88, v89
    v_mov_b32 v89, v88
    s_nop 1
    v_permlane16_swap_b32 v88, v89
    s_nop 1
    v_add_f32 v88, v88, v89
    v_rcp_f32 v88, v88
    s_nop 0
    v_mul_f32 v80, v80, v88
    v_mul_f32 v81, v81, v88
    v_mul_f32 v82, v82, v88
    v_mul_f32 v83, v83, v88
    v_cvt_pk_bf16_f32 v92, v80, v81
    v_cvt_pk_bf16_f32 v93, v82, v83
    v_lshlrev_b32 v12, 3, v0
    ds_write_b64 v12, v[92:93] offset:8192
    s_cmp_lt_u32 s74, 31
    s_cbranch_scc1 L_hpoll
L_hfin:
    s_bitcmp1_b32 s75, 8
    s_mov_b32 s75, 0
    s_cbranch_scc1 L_hsm
    v_mov_b32 v13, 0
    ds_write_b32 v5, v13 offset:4
    s_waitcnt lgkmcnt(0)
L_end:
    s_endpgm
.section .rodata,"a"
.p2align 6
.amdhsa_kernel standalone__low_rank_proj_linformer__sampling_kernel
  .amdhsa_next_free_vgpr 300
  .amdhsa_next_free_sgpr 88
  .amdhsa_accum_offset 252
  .amdhsa_group_segment_fixed_size 0
  .amdhsa_kernarg_size 64
  .amdhsa_user_sgpr_count 2
  .amdhsa_user_sgpr_kernarg_segment_ptr 1
  .amdhsa_system_sgpr_workgroup_id_x 1
  .amdhsa_float_denorm_mode_32 3
.end_amdhsa_kernel
```
